```python
import torch

def _softmax(x, axis=-1):
    return torch.softmax(x, dim=axis)
def _gelu(x):
    return torch.nn.functional.gelu(x, approximate="tanh")
def _silu(x):
    return torch.nn.functional.silu(x)
def _sigmoid(x):
    return torch.sigmoid(x)
def _layernorm(x, axis=-1, eps=1e-5):
    m = x.mean(dim=axis, keepdim=True)
    v = x.var(dim=axis, keepdim=True, unbiased=False)
    return (x - m) / torch.sqrt(v + eps)
def _scatter_add(tgt, idx, src, axis=0):
    return tgt.clone().index_add_(axis, idx, src)
def _segment_sum(src, seg, n):
    out = torch.zeros((n,) + src.shape[1:], dtype=src.dtype)
    return out.index_add_(0, seg, src)
def _pad(x, pw):
    flat = tuple(v for pair in reversed(pw) for v in pair)
    return torch.nn.functional.pad(x, flat)

kernel_name = 'standalone__paged_block_table_kv_radixattention__decode'

def setup_inputs():

    _w = (lambda a: (lambda t: t.to(torch.bfloat16) if t.is_floating_point() else t)(torch.as_tensor(a)))
    B, H, Hkv, Dh = 1, 32, 16, 128
    Lk = 8192
    bs = 16
    nb = max(2, Lk // bs)
    P = max(1, nb // 2)
    n_phys = P + B * (nb - P)
    shared = torch.arange(P, dtype=torch.int64)
    priv = P + torch.arange(B * (nb - P), dtype=torch.int64).reshape(B, nb - P)
    bt = torch.cat([torch.tile(shared[None, :], (B, 1)), priv], dim=1)
    ctx = nb * bs - (torch.arange(1, B + 1, dtype=torch.int64) * 2654435761) % max(1, (nb * bs - P * bs) // 2)
    return {
        "q": _w((lambda *s: torch.randn(*s, dtype=torch.bfloat16) * 0.8)(B, H, Dh)),
        "k_cache": _w((lambda *s: torch.randn(*s, dtype=torch.bfloat16) * 0.8)(n_phys, bs, Hkv, Dh)),
        "v_cache": _w((lambda *s: torch.randn(*s, dtype=torch.bfloat16) * 0.05)(n_phys, bs, Hkv, Dh)),
        "block_table": _w(bt.to(torch.int64)),
        "ctx_lens": _w(torch.as_tensor(ctx).to(torch.int64)),
    }

def reference(q, k_cache, v_cache, block_table, ctx_lens):
    B, H, Dh = q.shape
    n_phys, bs, Hkv, _ = k_cache.shape
    nb = block_table.shape[1]
    Lk = nb * bs
    rep = H // Hkv
    k = k_cache[block_table].reshape(B, Lk, Hkv, Dh)
    v = v_cache[block_table].reshape(B, Lk, Hkv, Dh)
    k = (lambda x, n, axis: torch.repeat_interleave(x, n, dim=axis))(k, rep, axis=2)
    v = (lambda x, n, axis: torch.repeat_interleave(x, n, dim=axis))(v, rep, axis=2)
    scores = torch.einsum("bhd,bkhd->bhk", q, k) * (Dh ** -0.5)
    pos = torch.arange(Lk)
    valid = pos[None, :] < ctx_lens[:, None]
    scores = torch.where(valid[:, None, :], scores, -1e9)
    p = _softmax(scores, axis=-1)
    return torch.einsum("bhk,bkhd->bhd", p, v)
```

```asm
; @launch grid=(256,1,1) block=(576,1,1) lds=8352
.amdgcn_target "amdgcn-amd-amdhsa--gfx950"
.text
.globl standalone__paged_block_table_kv_radixattention__decode_kernel
.p2align 8
.type standalone__paged_block_table_kv_radixattention__decode_kernel,@function
standalone__paged_block_table_kv_radixattention__decode_kernel:
    s_cmp_ge_u32 s2, 256
    s_cbranch_scc1 L_end
    s_load_dwordx16 s[4:19], s[0:1], 0
    v_lshrrev_b32 v1, 6, v0
    v_and_b32 v0, 63, v0
    v_readfirstlane_b32 s32, v1
    v_mov_b32 v10, 0
    v_lshlrev_b32 v4, 2, v0
    s_mov_b64 exec, 0xf
    ds_write_b32 v4, v10 offset:8336
    s_mov_b64 exec, -1
    s_and_b32 s33, s2, 15
    s_lshr_b32 s34, s2, 4
    s_lshl_b32 s44, s34, 5
    s_and_b32 s37, s32, 7
    s_lshl_b32 s37, s37, 2
    s_add_u32 s44, s44, s37
    s_lshl_b32 s37, s44, 2
    v_lshrrev_b32 v2, 4, v0
    s_mov_b32 s42, 0x2000000
    s_mov_b32 s23, 0x00020000
    s_mov_b32 s27, 0x00020000
    s_lshl_b32 s43, s33, 8
    s_mov_b32 s39, 0x3e0293ee
    v_and_b32 v8, 15, v0
    v_lshlrev_b32 v30, 12, v2
    v_lshl_add_u32 v30, v8, 4, v30
    v_add_u32 v30, s43, v30
    v_and_b32 v5, 3, v0
    v_lshlrev_b32 v5, 4, v5
    v_lshl_add_u32 v5, v2, 6, v5
    v_bfe_u32 v11, v0, 2, 2
    v_lshl_add_u32 v1, v11, 12, v5
    v_add_u32 v1, s43, v1
    v_bfe_u32 v11, v0, 2, 1
    v_lshl_add_u32 v11, v11, 8, v5
    s_lshl_b32 s56, s33, 9
    v_add_u32 v11, s56, v11
    s_waitcnt lgkmcnt(0)
    s_load_dwordx4 s[28:31], s[10:11], s37
    s_load_dword s36, s[12:13], 0
    global_load_dwordx4 v[12:15], v11, s[4:5]
    s_mov_b32 s20, s6
    s_and_b32 s21, s7, 0xffff
    s_mov_b32 s24, s8
    s_and_b32 s25, s9, 0xffff
    s_lshl_b32 s44, s44, 4
    v_mov_b32 v3, 0xff800000
    v_mov_b32 v11, 1
    s_barrier
    s_cmp_eq_u32 s32, 8
    s_cbranch_scc1 L_svc
    s_setprio 2
    s_mov_b32 s40, 0x05040100
    s_mov_b32 s41, 0x07060302
    s_waitcnt lgkmcnt(0)
    s_cmp_le_i32 s36, 0
    s_cselect_b32 s39, 0, s39
    s_cselect_b32 s36, 0x2000, s36
    s_min_i32 s36, s36, 0x2000
    s_sub_i32 s38, s36, s44
    s_lshl_b32 s28, s28, 16
    s_lshl_b32 s29, s29, 16
    s_lshl_b32 s30, s30, 16
    s_lshl_b32 s31, s31, 16
    s_cmp_gt_i32 s38, 0
    s_cselect_b32 s22, s42, 0
    buffer_load_dwordx4 v[32:35], v1, s[20:23], s28 offen nt
    s_cmp_gt_i32 s38, 0
    s_cselect_b32 s26, s42, 0
    buffer_load_dwordx4 v[36:39], v30, s[24:27], s28 offen nt
    s_add_u32 s61, s28, 16384
    s_cmp_gt_i32 s38, 4
    s_cselect_b32 s26, s42, 0
    buffer_load_dwordx4 v[40:43], v30, s[24:27], s61 offen nt
    s_add_u32 s61, s28, 16384
    s_cmp_gt_i32 s38, 4
    s_cselect_b32 s22, s42, 0
    s_waitcnt vmcnt(2)
    buffer_load_dwordx4 v[44:47], v1, s[20:23], s61 offen nt
    v_mfma_f32_16x16x32_bf16 v[64:67], v[32:35], v[12:15], 0
    s_add_u32 s61, s28, 32768
    s_cmp_gt_i32 s38, 8
    s_cselect_b32 s22, s42, 0
    s_waitcnt vmcnt(2)
    buffer_load_dwordx4 v[48:51], v1, s[20:23], s61 offen nt
    s_add_u32 s61, s28, 49152
    s_cmp_gt_i32 s38, 12
    s_cselect_b32 s22, s42, 0
    s_waitcnt vmcnt(2)
    buffer_load_dwordx4 v[52:55], v1, s[20:23], s61 offen nt
    v_perm_b32 v128, v40, v36, s40
    v_perm_b32 v132, v40, v36, s41
    v_perm_b32 v136, v41, v37, s40
    v_perm_b32 v140, v41, v37, s41
    v_perm_b32 v144, v42, v38, s40
    v_perm_b32 v148, v42, v38, s41
    v_perm_b32 v152, v43, v39, s40
    v_perm_b32 v156, v43, v39, s41
    s_cmp_gt_i32 s38, 16
    s_cselect_b32 s22, s42, 0
    s_waitcnt vmcnt(2)
    buffer_load_dwordx4 v[56:59], v1, s[20:23], s29 offen nt
    v_mfma_f32_16x16x32_bf16 v[68:71], v[44:47], v[12:15], 0
    s_nop 3
    v_mov_b32_dpp v72, v64 quad_perm:[0,0,0,0] row_mask:0xf bank_mask:0xf
    s_nop 1
    v_add_f32_dpp v72, v65, v72 quad_perm:[1,1,1,1] row_mask:0xf bank_mask:0xf
    s_nop 1
    v_add_f32_dpp v72, v66, v72 quad_perm:[2,2,2,2] row_mask:0xf bank_mask:0xf
    s_nop 1
    v_add_f32_dpp v72, v67, v72 quad_perm:[3,3,3,3] row_mask:0xf bank_mask:0xf
    s_add_u32 s61, s29, 16384
    s_cmp_gt_i32 s38, 20
    s_cselect_b32 s22, s42, 0
    s_waitcnt vmcnt(2)
    buffer_load_dwordx4 v[60:63], v1, s[20:23], s61 offen nt
    v_mfma_f32_16x16x32_bf16 v[64:67], v[48:51], v[12:15], 0
    v_mov_b32_dpp v73, v68 quad_perm:[0,0,0,0] row_mask:0xf bank_mask:0xf
    s_nop 1
    v_add_f32_dpp v73, v69, v73 quad_perm:[1,1,1,1] row_mask:0xf bank_mask:0xf
    s_nop 1
    v_add_f32_dpp v73, v70, v73 quad_perm:[2,2,2,2] row_mask:0xf bank_mask:0xf
    s_nop 1
    v_add_f32_dpp v73, v71, v73 quad_perm:[3,3,3,3] row_mask:0xf bank_mask:0xf
    s_add_u32 s61, s29, 32768
    s_cmp_gt_i32 s38, 24
    s_cselect_b32 s22, s42, 0
    s_waitcnt vmcnt(2)
    buffer_load_dwordx4 v[32:35], v1, s[20:23], s61 offen nt
    v_mfma_f32_16x16x32_bf16 v[68:71], v[52:55], v[12:15], 0
    v_mov_b32_dpp v74, v64 quad_perm:[0,0,0,0] row_mask:0xf bank_mask:0xf
    s_nop 1
    v_add_f32_dpp v74, v65, v74 quad_perm:[1,1,1,1] row_mask:0xf bank_mask:0xf
    s_nop 1
    v_add_f32_dpp v74, v66, v74 quad_perm:[2,2,2,2] row_mask:0xf bank_mask:0xf
    s_nop 1
    v_add_f32_dpp v74, v67, v74 quad_perm:[3,3,3,3] row_mask:0xf bank_mask:0xf
    s_add_u32 s61, s29, 49152
    s_cmp_gt_i32 s38, 28
    s_cselect_b32 s22, s42, 0
    s_waitcnt vmcnt(2)
    buffer_load_dwordx4 v[36:39], v1, s[20:23], s61 offen nt
    v_mfma_f32_16x16x32_bf16 v[64:67], v[56:59], v[12:15], 0
    v_mov_b32_dpp v75, v68 quad_perm:[0,0,0,0] row_mask:0xf bank_mask:0xf
    s_nop 1
    v_add_f32_dpp v75, v69, v75 quad_perm:[1,1,1,1] row_mask:0xf bank_mask:0xf
    s_nop 1
    v_add_f32_dpp v75, v70, v75 quad_perm:[2,2,2,2] row_mask:0xf bank_mask:0xf
    s_nop 1
    v_add_f32_dpp v75, v71, v75 quad_perm:[3,3,3,3] row_mask:0xf bank_mask:0xf
    s_cmp_gt_i32 s38, 32
    s_cselect_b32 s22, s42, 0
    s_waitcnt vmcnt(2)
    buffer_load_dwordx4 v[40:43], v1, s[20:23], s30 offen nt
    v_mfma_f32_16x16x32_bf16 v[68:71], v[60:63], v[12:15], 0
    v_mov_b32_dpp v76, v64 quad_perm:[0,0,0,0] row_mask:0xf bank_mask:0xf
    s_nop 1
    v_add_f32_dpp v76, v65, v76 quad_perm:[1,1,1,1] row_mask:0xf bank_mask:0xf
    s_nop 1
    v_add_f32_dpp v76, v66, v76 quad_perm:[2,2,2,2] row_mask:0xf bank_mask:0xf
    s_nop 1
    v_add_f32_dpp v76, v67, v76 quad_perm:[3,3,3,3] row_mask:0xf bank_mask:0xf
    s_add_u32 s61, s30, 16384
    s_cmp_gt_i32 s38, 36
    s_cselect_b32 s22, s42, 0
    s_waitcnt vmcnt(2)
    buffer_load_dwordx4 v[44:47], v1, s[20:23], s61 offen nt
    v_mfma_f32_16x16x32_bf16 v[64:67], v[32:35], v[12:15], 0
    v_mov_b32_dpp v77, v68 quad_perm:[0,0,0,0] row_mask:0xf bank_mask:0xf
    s_nop 1
    v_add_f32_dpp v77, v69, v77 quad_perm:[1,1,1,1] row_mask:0xf bank_mask:0xf
    s_nop 1
    v_add_f32_dpp v77, v70, v77 quad_perm:[2,2,2,2] row_mask:0xf bank_mask:0xf
    s_nop 1
    v_add_f32_dpp v77, v71, v77 quad_perm:[3,3,3,3] row_mask:0xf bank_mask:0xf
    s_add_u32 s61, s30, 32768
    s_cmp_gt_i32 s38, 40
    s_cselect_b32 s22, s42, 0
    s_waitcnt vmcnt(2)
    buffer_load_dwordx4 v[48:51], v1, s[20:23], s61 offen nt
    v_mfma_f32_16x16x32_bf16 v[68:71], v[36:39], v[12:15], 0
    v_mov_b32_dpp v78, v64 quad_perm:[0,0,0,0] row_mask:0xf bank_mask:0xf
    s_nop 1
    v_add_f32_dpp v78, v65, v78 quad_perm:[1,1,1,1] row_mask:0xf bank_mask:0xf
    s_nop 1
    v_add_f32_dpp v78, v66, v78 quad_perm:[2,2,2,2] row_mask:0xf bank_mask:0xf
    s_nop 1
    v_add_f32_dpp v78, v67, v78 quad_perm:[3,3,3,3] row_mask:0xf bank_mask:0xf
    s_add_u32 s61, s30, 49152
    s_cmp_gt_i32 s38, 44
    s_cselect_b32 s22, s42, 0
    s_waitcnt vmcnt(2)
    buffer_load_dwordx4 v[52:55], v1, s[20:23], s61 offen nt
    v_mfma_f32_16x16x32_bf16 v[64:67], v[40:43], v[12:15], 0
    v_mov_b32_dpp v79, v68 quad_perm:[0,0,0,0] row_mask:0xf bank_mask:0xf
    s_nop 1
    v_add_f32_dpp v79, v69, v79 quad_perm:[1,1,1,1] row_mask:0xf bank_mask:0xf
    s_nop 1
    v_add_f32_dpp v79, v70, v79 quad_perm:[2,2,2,2] row_mask:0xf bank_mask:0xf
    s_nop 1
    v_add_f32_dpp v79, v71, v79 quad_perm:[3,3,3,3] row_mask:0xf bank_mask:0xf
    s_cmp_gt_i32 s38, 48
    s_cselect_b32 s22, s42, 0
    s_waitcnt vmcnt(2)
    buffer_load_dwordx4 v[56:59], v1, s[20:23], s31 offen nt
    v_mfma_f32_16x16x32_bf16 v[68:71], v[44:47], v[12:15], 0
    v_mov_b32_dpp v80, v64 quad_perm:[0,0,0,0] row_mask:0xf bank_mask:0xf
    s_nop 1
    v_add_f32_dpp v80, v65, v80 quad_perm:[1,1,1,1] row_mask:0xf bank_mask:0xf
    s_nop 1
    v_add_f32_dpp v80, v66, v80 quad_perm:[2,2,2,2] row_mask:0xf bank_mask:0xf
    s_nop 1
    v_add_f32_dpp v80, v67, v80 quad_perm:[3,3,3,3] row_mask:0xf bank_mask:0xf
    s_add_u32 s61, s31, 16384
    s_cmp_gt_i32 s38, 52
    s_cselect_b32 s22, s42, 0
    s_waitcnt vmcnt(2)
    buffer_load_dwordx4 v[60:63], v1, s[20:23], s61 offen nt
    v_mfma_f32_16x16x32_bf16 v[64:67], v[48:51], v[12:15], 0
    v_mov_b32_dpp v81, v68 quad_perm:[0,0,0,0] row_mask:0xf bank_mask:0xf
    s_nop 1
    v_add_f32_dpp v81, v69, v81 quad_perm:[1,1,1,1] row_mask:0xf bank_mask:0xf
    s_nop 1
    v_add_f32_dpp v81, v70, v81 quad_perm:[2,2,2,2] row_mask:0xf bank_mask:0xf
    s_nop 1
    v_add_f32_dpp v81, v71, v81 quad_perm:[3,3,3,3] row_mask:0xf bank_mask:0xf
    s_mov_b64 exec, 1
    ds_add_u32 v10, v11 offset:8336
    s_mov_b64 exec, -1
    s_add_u32 s61, s31, 32768
    s_cmp_gt_i32 s38, 56
    s_cselect_b32 s22, s42, 0
    s_waitcnt vmcnt(2)
    buffer_load_dwordx4 v[32:35], v1, s[20:23], s61 offen nt
    v_mfma_f32_16x16x32_bf16 v[68:71], v[52:55], v[12:15], 0
    v_mov_b32_dpp v82, v64 quad_perm:[0,0,0,0] row_mask:0xf bank_mask:0xf
    s_nop 1
    v_add_f32_dpp v82, v65, v82 quad_perm:[1,1,1,1] row_mask:0xf bank_mask:0xf
    s_nop 1
    v_add_f32_dpp v82, v66, v82 quad_perm:[2,2,2,2] row_mask:0xf bank_mask:0xf
    s_nop 1
    v_add_f32_dpp v82, v67, v82 quad_perm:[3,3,3,3] row_mask:0xf bank_mask:0xf
    s_add_u32 s61, s31, 49152
    s_cmp_gt_i32 s38, 60
    s_cselect_b32 s22, s42, 0
    s_waitcnt vmcnt(2)
    buffer_load_dwordx4 v[36:39], v1, s[20:23], s61 offen nt
    v_mfma_f32_16x16x32_bf16 v[64:67], v[56:59], v[12:15], 0
    v_mov_b32_dpp v83, v68 quad_perm:[0,0,0,0] row_mask:0xf bank_mask:0xf
    s_nop 1
    v_add_f32_dpp v83, v69, v83 quad_perm:[1,1,1,1] row_mask:0xf bank_mask:0xf
    s_nop 1
    v_add_f32_dpp v83, v70, v83 quad_perm:[2,2,2,2] row_mask:0xf bank_mask:0xf
    s_nop 1
    v_add_f32_dpp v83, v71, v83 quad_perm:[3,3,3,3] row_mask:0xf bank_mask:0xf
    s_add_u32 s61, s28, 32768
    s_cmp_gt_i32 s38, 8
    s_cselect_b32 s26, s42, 0
    s_waitcnt vmcnt(2)
    buffer_load_dwordx4 v[40:43], v30, s[24:27], s61 offen nt
    v_mfma_f32_16x16x32_bf16 v[68:71], v[60:63], v[12:15], 0
    v_mov_b32_dpp v84, v64 quad_perm:[0,0,0,0] row_mask:0xf bank_mask:0xf
    s_nop 1
    v_add_f32_dpp v84, v65, v84 quad_perm:[1,1,1,1] row_mask:0xf bank_mask:0xf
    s_nop 1
    v_add_f32_dpp v84, v66, v84 quad_perm:[2,2,2,2] row_mask:0xf bank_mask:0xf
    s_nop 1
    v_add_f32_dpp v84, v67, v84 quad_perm:[3,3,3,3] row_mask:0xf bank_mask:0xf
    s_add_u32 s61, s28, 49152
    s_cmp_gt_i32 s38, 12
    s_cselect_b32 s26, s42, 0
    s_waitcnt vmcnt(2)
    buffer_load_dwordx4 v[44:47], v30, s[24:27], s61 offen nt
    v_mfma_f32_16x16x32_bf16 v[64:67], v[32:35], v[12:15], 0
    v_mov_b32_dpp v85, v68 quad_perm:[0,0,0,0] row_mask:0xf bank_mask:0xf
    s_nop 1
    v_add_f32_dpp v85, v69, v85 quad_perm:[1,1,1,1] row_mask:0xf bank_mask:0xf
    s_nop 1
    v_add_f32_dpp v85, v70, v85 quad_perm:[2,2,2,2] row_mask:0xf bank_mask:0xf
    s_nop 1
    v_add_f32_dpp v85, v71, v85 quad_perm:[3,3,3,3] row_mask:0xf bank_mask:0xf
    s_cmp_gt_i32 s38, 16
    s_cselect_b32 s26, s42, 0
    s_waitcnt vmcnt(2)
    buffer_load_dwordx4 v[48:51], v30, s[24:27], s29 offen nt
    v_mfma_f32_16x16x32_bf16 v[68:71], v[36:39], v[12:15], 0
    v_mov_b32_dpp v86, v64 quad_perm:[0,0,0,0] row_mask:0xf bank_mask:0xf
    s_nop 1
    v_add_f32_dpp v86, v65, v86 quad_perm:[1,1,1,1] row_mask:0xf bank_mask:0xf
    s_nop 1
    v_add_f32_dpp v86, v66, v86 quad_perm:[2,2,2,2] row_mask:0xf bank_mask:0xf
    s_nop 1
    v_add_f32_dpp v86, v67, v86 quad_perm:[3,3,3,3] row_mask:0xf bank_mask:0xf
    s_add_u32 s61, s29, 16384
    s_cmp_gt_i32 s38, 20
    s_cselect_b32 s26, s42, 0
    s_waitcnt vmcnt(2)
    buffer_load_dwordx4 v[52:55], v30, s[24:27], s61 offen nt
    v_mov_b32_dpp v87, v68 quad_perm:[0,0,0,0] row_mask:0xf bank_mask:0xf
    s_nop 1
    v_add_f32_dpp v87, v69, v87 quad_perm:[1,1,1,1] row_mask:0xf bank_mask:0xf
    s_nop 1
    v_add_f32_dpp v87, v70, v87 quad_perm:[2,2,2,2] row_mask:0xf bank_mask:0xf
    s_nop 1
    v_add_f32_dpp v87, v71, v87 quad_perm:[3,3,3,3] row_mask:0xf bank_mask:0xf
    v_bfe_u32 v4, v0, 2, 1
    v_lshlrev_b32 v4, 5, v4
    s_lshl_b32 s37, s32, 2
    v_add_u32 v5, s37, v4
    v_lshrrev_b32 v4, 3, v4
    s_cmp_ge_i32 s38, 64
    s_cbranch_scc1 L_nomask
    s_sub_i32 s56, s38, 0
    s_sub_i32 s57, s38, 4
    s_sub_i32 s58, s38, 8
    s_sub_i32 s59, s38, 12
    v_cmp_gt_i32 s[48:49], s56, v2
    v_cmp_gt_i32 s[50:51], s57, v2
    v_cmp_gt_i32 s[52:53], s58, v2
    v_cmp_gt_i32 s[54:55], s59, v2
    v_cndmask_b32 v72, v3, v72, s[48:49]
    v_cndmask_b32 v73, v3, v73, s[50:51]
    v_cndmask_b32 v74, v3, v74, s[52:53]
    v_cndmask_b32 v75, v3, v75, s[54:55]
    s_sub_i32 s56, s38, 16
    s_sub_i32 s57, s38, 20
    s_sub_i32 s58, s38, 24
    s_sub_i32 s59, s38, 28
    v_cmp_gt_i32 s[48:49], s56, v2
    v_cmp_gt_i32 s[50:51], s57, v2
    v_cmp_gt_i32 s[52:53], s58, v2
    v_cmp_gt_i32 s[54:55], s59, v2
    v_cndmask_b32 v76, v3, v76, s[48:49]
    v_cndmask_b32 v77, v3, v77, s[50:51]
    v_cndmask_b32 v78, v3, v78, s[52:53]
    v_cndmask_b32 v79, v3, v79, s[54:55]
    s_sub_i32 s56, s38, 32
    s_sub_i32 s57, s38, 36
    s_sub_i32 s58, s38, 40
    s_sub_i32 s59, s38, 44
    v_cmp_gt_i32 s[48:49], s56, v2
    v_cmp_gt_i32 s[50:51], s57, v2
    v_cmp_gt_i32 s[52:53], s58, v2
    v_cmp_gt_i32 s[54:55], s59, v2
    v_cndmask_b32 v80, v3, v80, s[48:49]
    v_cndmask_b32 v81, v3, v81, s[50:51]
    v_cndmask_b32 v82, v3, v82, s[52:53]
    v_cndmask_b32 v83, v3, v83, s[54:55]
    s_sub_i32 s56, s38, 48
    s_sub_i32 s57, s38, 52
    s_sub_i32 s58, s38, 56
    s_sub_i32 s59, s38, 60
    v_cmp_gt_i32 s[48:49], s56, v2
    v_cmp_gt_i32 s[50:51], s57, v2
    v_cmp_gt_i32 s[52:53], s58, v2
    v_cmp_gt_i32 s[54:55], s59, v2
    v_cndmask_b32 v84, v3, v84, s[48:49]
    v_cndmask_b32 v85, v3, v85, s[50:51]
    v_cndmask_b32 v86, v3, v86, s[52:53]
    v_cndmask_b32 v87, v3, v87, s[54:55]
L_nomask:
    v_mov_b32 v6, 0xff7fffff
    v_max3_f32 v7, v72, v73, v74
    v_max3_f32 v6, v6, v75, v76
    v_max3_f32 v7, v7, v77, v78
    v_max3_f32 v6, v6, v79, v80
    v_max3_f32 v7, v7, v81, v82
    v_max3_f32 v6, v6, v83, v84
    v_max3_f32 v7, v7, v85, v86
    v_max3_f32 v6, v6, v87, v7
    v_mov_b32 v7, v6
    s_nop 1
    v_permlane16_swap_b32 v6, v7
    s_nop 1
    v_max_f32 v6, v6, v7
    v_mov_b32 v7, v6
    s_nop 1
    v_permlane32_swap_b32 v6, v7
    s_nop 1
    v_max_f32 v6, v6, v7
    v_mul_f32 v7, s39, v6
    s_add_u32 s61, s29, 32768
    s_cmp_gt_i32 s38, 24
    s_cselect_b32 s26, s42, 0
    s_waitcnt vmcnt(2)
    buffer_load_dwordx4 v[56:59], v30, s[24:27], s61 offen nt
    v_perm_b32 v129, v44, v40, s40
    v_perm_b32 v133, v44, v40, s41
    v_perm_b32 v137, v45, v41, s40
    v_perm_b32 v141, v45, v41, s41
    v_perm_b32 v145, v46, v42, s40
    v_perm_b32 v149, v46, v42, s41
    v_perm_b32 v153, v47, v43, s40
    v_perm_b32 v157, v47, v43, s41
    v_fma_f32 v72, v72, s39, -v7
    v_fma_f32 v73, v73, s39, -v7
    v_fma_f32 v74, v74, s39, -v7
    v_fma_f32 v75, v75, s39, -v7
    v_fma_f32 v76, v76, s39, -v7
    v_fma_f32 v77, v77, s39, -v7
    v_fma_f32 v78, v78, s39, -v7
    v_fma_f32 v79, v79, s39, -v7
    v_exp_f32 v72, v72
    v_exp_f32 v73, v73
    v_exp_f32 v74, v74
    v_exp_f32 v75, v75
    v_exp_f32 v76, v76
    v_exp_f32 v77, v77
    v_exp_f32 v78, v78
    v_exp_f32 v79, v79
    s_nop 0
    v_cvt_pk_bf16_f32 v88, v72, v73
    v_cvt_pk_bf16_f32 v89, v74, v75
    v_cvt_pk_bf16_f32 v90, v76, v77
    v_cvt_pk_bf16_f32 v91, v78, v79
    s_add_u32 s61, s29, 49152
    s_cmp_gt_i32 s38, 28
    s_cselect_b32 s26, s42, 0
    s_waitcnt vmcnt(2)
    buffer_load_dwordx4 v[60:63], v30, s[24:27], s61 offen nt
    v_fma_f32 v80, v80, s39, -v7
    v_fma_f32 v81, v81, s39, -v7
    v_fma_f32 v82, v82, s39, -v7
    v_fma_f32 v83, v83, s39, -v7
    v_fma_f32 v84, v84, s39, -v7
    v_fma_f32 v85, v85, s39, -v7
    v_fma_f32 v86, v86, s39, -v7
    v_fma_f32 v87, v87, s39, -v7
    v_exp_f32 v80, v80
    v_exp_f32 v81, v81
    v_exp_f32 v82, v82
    v_exp_f32 v83, v83
    v_exp_f32 v84, v84
    v_exp_f32 v85, v85
    v_exp_f32 v86, v86
    v_exp_f32 v87, v87
    s_nop 0
    v_cvt_pk_bf16_f32 v92, v80, v81
    v_cvt_pk_bf16_f32 v93, v82, v83
    v_cvt_pk_bf16_f32 v94, v84, v85
    v_cvt_pk_bf16_f32 v95, v86, v87
    s_cmp_gt_i32 s38, 32
    s_cselect_b32 s26, s42, 0
    s_waitcnt vmcnt(2)
    buffer_load_dwordx4 v[32:35], v30, s[24:27], s30 offen nt
    s_add_u32 s61, s30, 16384
    s_cmp_gt_i32 s38, 36
    s_cselect_b32 s26, s42, 0
    buffer_load_dwordx4 v[36:39], v30, s[24:27], s61 offen nt
    s_add_u32 s61, s30, 32768
    s_cmp_gt_i32 s38, 40
    s_cselect_b32 s26, s42, 0
    buffer_load_dwordx4 v[40:43], v30, s[24:27], s61 offen nt
    s_add_u32 s61, s30, 49152
    s_cmp_gt_i32 s38, 44
    s_cselect_b32 s26, s42, 0
    buffer_load_dwordx4 v[44:47], v30, s[24:27], s61 offen nt
    v_perm_b32 v130, v52, v48, s40
    v_perm_b32 v134, v52, v48, s41
    v_perm_b32 v138, v53, v49, s40
    v_perm_b32 v142, v53, v49, s41
    v_perm_b32 v146, v54, v50, s40
    v_perm_b32 v150, v54, v50, s41
    v_perm_b32 v154, v55, v51, s40
    v_perm_b32 v158, v55, v51, s41
    v_pk_add_f32 v[72:73], v[72:73], v[74:75]
    v_pk_add_f32 v[76:77], v[76:77], v[78:79]
    v_pk_add_f32 v[72:73], v[72:73], v[80:81]
    v_pk_add_f32 v[76:77], v[76:77], v[82:83]
    v_pk_add_f32 v[72:73], v[72:73], v[84:85]
    v_pk_add_f32 v[76:77], v[76:77], v[86:87]
    v_pk_add_f32 v[72:73], v[72:73], v[76:77]
    v_add_f32 v9, v72, v73
    v_mov_b32 v6, v9
    s_nop 1
    v_permlane16_swap_b32 v9, v6
    s_nop 1
    v_add_f32 v9, v9, v6
    v_mov_b32 v6, v9
    s_nop 1
    v_permlane32_swap_b32 v9, v6
    s_nop 1
    v_add_f32 v9, v9, v6
    s_mov_b64 exec, 0x11
    ds_write_b32 v5, v7 offset:8192
    ds_write_b32 v5, v9 offset:8256
    s_mov_b64 exec, 1
    ds_add_u32 v10, v11 offset:8344
    s_mov_b64 exec, -1
    v_lshlrev_b32 v8, 5, v8
    v_lshl_add_u32 v8, v2, 9, v8
    s_lshl_b32 s37, s32, 10
    v_add_u32 v8, s37, v8
    s_cmp_gt_i32 s38, 48
    s_cselect_b32 s26, s42, 0
    s_waitcnt vmcnt(5)
    buffer_load_dwordx4 v[48:51], v30, s[24:27], s31 offen nt
    s_add_u32 s61, s31, 16384
    s_cmp_gt_i32 s38, 52
    s_cselect_b32 s26, s42, 0
    s_waitcnt vmcnt(5)
    buffer_load_dwordx4 v[52:55], v30, s[24:27], s61 offen nt
    v_perm_b32 v131, v60, v56, s40
    v_perm_b32 v135, v60, v56, s41
    v_perm_b32 v139, v61, v57, s40
    v_perm_b32 v143, v61, v57, s41
    v_perm_b32 v147, v62, v58, s40
    v_perm_b32 v151, v62, v58, s41
    v_perm_b32 v155, v63, v59, s40
    v_perm_b32 v159, v63, v59, s41
    s_add_u32 s61, s31, 32768
    s_cmp_gt_i32 s38, 56
    s_cselect_b32 s26, s42, 0
    s_waitcnt vmcnt(5)
    buffer_load_dwordx4 v[56:59], v30, s[24:27], s61 offen nt
    v_mfma_f32_16x16x32_bf16 v[128:131], v[88:91], v[128:131], 0
    v_mfma_f32_16x16x32_bf16 v[132:135], v[88:91], v[132:135], 0
    v_mfma_f32_16x16x32_bf16 v[136:139], v[88:91], v[136:139], 0
    v_mfma_f32_16x16x32_bf16 v[140:143], v[88:91], v[140:143], 0
    v_mfma_f32_16x16x32_bf16 v[144:147], v[88:91], v[144:147], 0
    v_mfma_f32_16x16x32_bf16 v[148:151], v[88:91], v[148:151], 0
    v_mfma_f32_16x16x32_bf16 v[152:155], v[88:91], v[152:155], 0
    v_mfma_f32_16x16x32_bf16 v[156:159], v[88:91], v[156:159], 0
    s_add_u32 s61, s31, 49152
    s_cmp_gt_i32 s38, 60
    s_cselect_b32 s26, s42, 0
    s_waitcnt vmcnt(5)
    buffer_load_dwordx4 v[60:63], v30, s[24:27], s61 offen nt
    v_perm_b32 v96, v36, v32, s40
    v_perm_b32 v100, v36, v32, s41
    v_perm_b32 v104, v37, v33, s40
    v_perm_b32 v108, v37, v33, s41
    v_perm_b32 v112, v38, v34, s40
    v_perm_b32 v116, v38, v34, s41
    v_perm_b32 v120, v39, v35, s40
    v_perm_b32 v124, v39, v35, s41
    s_waitcnt vmcnt(5)
    s_waitcnt vmcnt(4)
    v_perm_b32 v97, v44, v40, s40
    v_perm_b32 v101, v44, v40, s41
    v_perm_b32 v105, v45, v41, s40
    v_perm_b32 v109, v45, v41, s41
    v_perm_b32 v113, v46, v42, s40
    v_perm_b32 v117, v46, v42, s41
    v_perm_b32 v121, v47, v43, s40
    v_perm_b32 v125, v47, v43, s41
    s_waitcnt vmcnt(3)
    s_waitcnt vmcnt(2)
    v_perm_b32 v98, v52, v48, s40
    v_perm_b32 v102, v52, v48, s41
    v_perm_b32 v106, v53, v49, s40
    v_perm_b32 v110, v53, v49, s41
    v_perm_b32 v114, v54, v50, s40
    v_perm_b32 v118, v54, v50, s41
    v_perm_b32 v122, v55, v51, s40
    v_perm_b32 v126, v55, v51, s41
    s_waitcnt vmcnt(1)
    s_waitcnt vmcnt(0)
    v_perm_b32 v99, v60, v56, s40
    v_perm_b32 v103, v60, v56, s41
    v_perm_b32 v107, v61, v57, s40
    v_perm_b32 v111, v61, v57, s41
    v_perm_b32 v115, v62, v58, s40
    v_perm_b32 v119, v62, v58, s41
    v_perm_b32 v123, v63, v59, s40
    v_perm_b32 v127, v63, v59, s41
    v_mfma_f32_16x16x32_bf16 v[128:131], v[92:95], v[96:99], v[128:131]
    v_mfma_f32_16x16x32_bf16 v[132:135], v[92:95], v[100:103], v[132:135]
    v_mfma_f32_16x16x32_bf16 v[136:139], v[92:95], v[104:107], v[136:139]
    v_mfma_f32_16x16x32_bf16 v[140:143], v[92:95], v[108:111], v[140:143]
    v_mfma_f32_16x16x32_bf16 v[144:147], v[92:95], v[112:115], v[144:147]
    v_mfma_f32_16x16x32_bf16 v[148:151], v[92:95], v[116:119], v[148:151]
    v_mfma_f32_16x16x32_bf16 v[152:155], v[92:95], v[120:123], v[152:155]
    v_mfma_f32_16x16x32_bf16 v[156:159], v[92:95], v[124:127], v[156:159]
    s_mov_b32 exec_hi, 0
    s_nop 1
    ds_write2_b32 v8, v128, v132 offset0:0 offset1:1
    s_nop 0
    ds_write2_b32 v8, v136, v140 offset0:2 offset1:3
    s_nop 0
    ds_write2_b32 v8, v144, v148 offset0:4 offset1:5
    s_nop 0
    ds_write2_b32 v8, v152, v156 offset0:6 offset1:7
    s_mov_b64 exec, 1
    ds_add_u32 v10, v11 offset:8348
    s_branch L_exit
L_svc:
    s_getreg_b32 s48, hwreg(HW_REG_XCC_ID, 0, 4)
    s_or_b32 s48, s48, 0x10
    s_mul_i32 s49, s48, 0x01010101
    s_lshl_b32 s45, s33, 4
    s_add_u32 s45, s45, s34
    s_lshl_b32 s45, s45, 10
    s_lshl_b32 s46, s33, 11
    s_add_u32 s46, s46, 262144
    v_lshlrev_b32 v8, 4, v0
    s_lshl_b32 s37, s33, 3
    v_mov_b32 v1, s37
    s_lshl_b32 s37, s33, 2
    v_mov_b32 v30, s37
    v_mov_b32 v6, s48
    s_and_b32 s47, s34, 3
    s_cmp_lg_u32 s47, 3
    s_cselect_b32 s40, 0, 1
    s_lshr_b32 s47, s34, 2
    s_cmp_eq_u32 s40, 0
    s_cbranch_scc1 L_noconf
    v_add_u32 v4, s47, v1
    s_mov_b64 exec, 1
    global_store_byte v4, v6, s[16:17] offset:132
    s_mov_b64 exec, -1
L_noconf:
    s_cmp_lg_u32 s34, 0
    s_cbranch_scc1 L_noclr
    s_lshl_b32 s56, s33, 14
    s_add_u32 s56, s56, 524288
    v_add_u32 v5, s56, v8
    s_add_u32 s56, s46, 524288
    v_add_u32 v4, s56, v8
    v_mov_b32 v16, -1
    v_mov_b32 v17, -1
    v_mov_b32 v18, -1
    v_mov_b32 v19, -1
    global_store_dwordx4 v4, v[16:19], s[18:19]
    global_store_dwordx4 v4, v[16:19], s[18:19] offset:1024
    global_store_dwordx4 v5, v[16:19], s[18:19] offset:0
    global_store_dwordx4 v5, v[16:19], s[18:19] offset:1024
    global_store_dwordx4 v5, v[16:19], s[18:19] offset:2048
    global_store_dwordx4 v5, v[16:19], s[18:19] offset:3072
    v_add_u32 v5, 0x1000, v5
    global_store_dwordx4 v5, v[16:19], s[18:19] offset:0
    global_store_dwordx4 v5, v[16:19], s[18:19] offset:1024
    global_store_dwordx4 v5, v[16:19], s[18:19] offset:2048
    global_store_dwordx4 v5, v[16:19], s[18:19] offset:3072
    v_add_u32 v5, 0x1000, v5
    global_store_dwordx4 v5, v[16:19], s[18:19] offset:0
    global_store_dwordx4 v5, v[16:19], s[18:19] offset:1024
    global_store_dwordx4 v5, v[16:19], s[18:19] offset:2048
    global_store_dwordx4 v5, v[16:19], s[18:19] offset:3072
    v_add_u32 v5, 0x1000, v5
    global_store_dwordx4 v5, v[16:19], s[18:19] offset:0
    global_store_dwordx4 v5, v[16:19], s[18:19] offset:1024
    global_store_dwordx4 v5, v[16:19], s[18:19] offset:2048
    global_store_dwordx4 v5, v[16:19], s[18:19] offset:3072
    s_waitcnt vmcnt(0)
    s_mov_b64 exec, 1
    global_store_byte v1, v6, s[16:17] offset:128
    s_mov_b64 exec, -1
L_noclr:
    s_waitcnt lgkmcnt(0)
    v_lshrrev_b32 v5, 5, v0
    v_lshlrev_b32 v4, 5, v5
    s_lshl_b32 s37, s34, 7
    s_add_u32 s37, s37, s46
    v_and_b32 v6, 15, v0
    v_lshlrev_b32 v6, 2, v6
    v_lshl_add_u32 v5, v5, 6, v6
    v_add_u32 v5, s37, v5
    s_mov_b32 s54, 0xff00ff00
    s_mov_b32 s55, 0xff00ff00
    s_mov_b32 s56, 0xfffffffe
    s_mov_b32 s60, 0x4000
    s_lshl_b32 s52, 1, s34
L_s0:
    ds_read_b32 v31, v10 offset:8336
    s_waitcnt lgkmcnt(0)
    v_readfirstlane_b32 s37, v31
    s_nop 3
    s_cmp_lt_u32 s37, 1
    s_cbranch_scc0 L_s0_go
    s_sleep 4
    s_branch L_s0
L_s0_go:
    s_mov_b32 s41, 24
L_cf:
    global_load_dwordx2 v[16:17], v1, s[16:17] offset:128 nt
    s_waitcnt vmcnt(0)
    v_readfirstlane_b32 s37, v16
    v_readfirstlane_b32 s43, v17
    s_nop 3
    s_and_b32 s37, s37, 0xff
    s_cmp_eq_u32 s37, s48
    s_cselect_b32 s51, 1, 0
    s_cmp_eq_u32 s43, s49
    s_cselect_b32 s50, s51, 0
    s_cmp_lg_u32 s50, 0
    s_cbranch_scc1 L_cf1
    s_sleep 4
    s_sub_u32 s41, s41, 1
    s_cbranch_scc0 L_cf
L_cf1:
L_s2:
    ds_read_b32 v31, v10 offset:8344
    s_waitcnt lgkmcnt(0)
    v_readfirstlane_b32 s37, v31
    s_nop 3
    s_cmp_lt_u32 s37, 8
    s_cbranch_scc0 L_s2_go
    s_sleep 2
    s_branch L_s2
L_s2_go:
    ds_read_b128 v[112:115], v4 offset:8192
    ds_read_b128 v[116:119], v4 offset:8208
    ds_read_b128 v[120:123], v4 offset:8256
    ds_read_b128 v[124:127], v4 offset:8272
    v_add_u32 v13, s45, v8
    v_add_u32 v12, 524288, v13
    s_waitcnt lgkmcnt(0)
    v_max3_f32 v7, v112, v113, v114
    v_max3_f32 v7, v7, v115, v116
    v_max3_f32 v7, v7, v117, v118
    v_max_f32 v7, v7, v119
    v_sub_f32 v112, v112, v7
    v_sub_f32 v113, v113, v7
    v_sub_f32 v114, v114, v7
    v_sub_f32 v115, v115, v7
    v_sub_f32 v116, v116, v7
    v_sub_f32 v117, v117, v7
    v_sub_f32 v118, v118, v7
    v_sub_f32 v119, v119, v7
    v_exp_f32 v112, v112
    v_exp_f32 v113, v113
    v_exp_f32 v114, v114
    v_exp_f32 v115, v115
    v_exp_f32 v116, v116
    v_exp_f32 v117, v117
    v_exp_f32 v118, v118
    v_exp_f32 v119, v119
    s_nop 0
    v_mul_f32 v9, v112, v120
    v_fmac_f32 v9, v113, v121
    v_fmac_f32 v9, v114, v122
    v_fmac_f32 v9, v115, v123
    v_fmac_f32 v9, v116, v124
    v_fmac_f32 v9, v117, v125
    v_fmac_f32 v9, v118, v126
    v_fmac_f32 v9, v119, v127
    v_cndmask_b32 v9, v7, v9, s[54:55]
    v_min_u32 v9, s56, v9
    s_mov_b32 exec_lo, 0xffff
    s_mov_b32 exec_hi, 0xffff
    s_cmp_eq_u32 s50, 0
    s_cbranch_scc1 L_mls
    v_add_u32 v5, 524288, v5
    global_store_dword v5, v9, s[18:19]
    s_branch L_mld
L_mls:
    global_store_dword v5, v9, s[18:19] sc1
    v_mov_b32 v6, s52
    s_waitcnt vmcnt(0)
    s_mov_b64 exec, 1
    global_atomic_or v30, v6, s[16:17]
L_mld:
    s_mov_b64 exec, -1
    s_cmp_eq_u32 s40, 0
    s_cbranch_scc1 L_fold
    v_and_b32 v6, 15, v0
    v_lshlrev_b32 v105, 7, v6
    v_bfe_u32 v4, v0, 4, 1
    v_lshl_add_u32 v105, v4, 5, v105
    s_lshr_b32 s37, s47, 1
    s_lshl_b32 s37, s37, 6
    s_add_u32 s37, s37, s46
    v_add_u32 v105, s37, v105
    v_add_u32 v104, 524288, v105
    v_lshlrev_b32 v4, 4, v6
    v_lshl_add_u32 v4, v2, 10, v4
    s_lshl_b32 s37, s33, 14
    s_lshl_b32 s43, s47, 8
    s_add_u32 s37, s37, s43
    v_add_u32 v4, s37, v4
    v_add_u32 v100, 528384, v4
    v_add_u32 v101, 536576, v4
    v_lshlrev_b32 v9, 3, v6
    v_lshl_add_u32 v9, v2, 1, v9
    s_lshl_b32 s37, s33, 9
    s_lshl_b32 s43, s47, 7
    s_add_u32 s37, s37, s43
    v_add_u32 v9, s37, v9
    v_lshlrev_b32 v11, 2, v2
L_pa2:
    s_cmp_eq_u32 s51, 0
    s_cbranch_scc1 L_pa2s
    s_mov_b32 s41, 16
L_pa2f:
    global_load_dword v28, v104, s[18:19] nt
    s_waitcnt vmcnt(0)
    v_cmp_eq_u32 vcc, -1, v28
    s_cbranch_vccz L_pa3
    s_sleep 4
    s_sub_u32 s41, s41, 1
    s_cbranch_scc0 L_pa2f
L_pa2s:
    s_sleep 8
    global_load_dwordx2 v[16:17], v1, s[16:17] offset:128 nt
    s_waitcnt vmcnt(0)
    v_readfirstlane_b32 s37, v16
    v_readfirstlane_b32 s43, v17
    s_nop 3
    s_and_b32 s37, s37, 0xff
    s_cmp_eq_u32 s37, s48
    s_cselect_b32 s51, 1, 0
    s_cmp_eq_u32 s43, s49
    s_cselect_b32 s50, s51, 0
    global_load_dword v31, v30, s[16:17] sc1
    s_sub_u32 s60, s60, 1
    s_cbranch_scc1 L_exit
    s_waitcnt vmcnt(0)
    v_bfe_u32 v31, v31, 0, 16
    s_nop 0
    v_readfirstlane_b32 s37, v31
    s_nop 3
    s_cmp_eq_u32 s37, 0xffff
    s_cselect_b32 s37, 1, s51
    s_cmp_eq_u32 s37, 0
    s_cbranch_scc1 L_pa2
    v_lshrrev_b32 v106, v6, v31
    v_and_b32 v106, 1, v106
    v_cmp_eq_u32 vcc, 1, v106
    s_nop 1
    v_cndmask_b32 v106, v104, v105, vcc
    global_load_dword v28, v106, s[18:19] sc1
    s_waitcnt vmcnt(0)
    v_cmp_eq_u32 vcc, -1, v28
    s_cbranch_vccnz L_pa2
L_pa3:
    v_mov_b32 v29, v28
    s_nop 1
    v_permlane16_swap_b32 v28, v29
    s_nop 1
    v_max_f32_dpp v3, v28, v28 row_ror:8 row_mask:0xf bank_mask:0xf
    s_nop 1
    v_max_f32_dpp v3, v3, v3 row_ror:4 row_mask:0xf bank_mask:0xf
    s_nop 1
    v_max_f32_dpp v3, v3, v3 row_ror:2 row_mask:0xf bank_mask:0xf
    s_nop 1
    v_max_f32_dpp v3, v3, v3 row_ror:1 row_mask:0xf bank_mask:0xf
    v_sub_f32 v28, v28, v3
    v_exp_f32 v28, v28
    s_nop 0
    v_mul_f32 v3, v28, v29
    s_nop 1
    v_add_f32_dpp v3, v3, v3 row_ror:8 row_mask:0xf bank_mask:0xf
    s_nop 1
    v_add_f32_dpp v3, v3, v3 row_ror:4 row_mask:0xf bank_mask:0xf
    s_nop 1
    v_add_f32_dpp v3, v3, v3 row_ror:2 row_mask:0xf bank_mask:0xf
    s_nop 1
    v_add_f32_dpp v3, v3, v3 row_ror:1 row_mask:0xf bank_mask:0xf
    v_rcp_f32 v3, v3
    s_nop 0
    v_mul_f32 v28, v28, v3
    ds_bpermute_b32 v20, v11, v28 offset:0
    ds_bpermute_b32 v21, v11, v28 offset:16
    ds_bpermute_b32 v22, v11, v28 offset:32
    ds_bpermute_b32 v23, v11, v28 offset:48
    s_waitcnt lgkmcnt(0)
L_fold:
L_s3:
    ds_read_b32 v31, v10 offset:8348
    s_waitcnt lgkmcnt(0)
    v_readfirstlane_b32 s37, v31
    s_nop 3
    s_cmp_lt_u32 s37, 8
    s_cbranch_scc1 L_s3
    ds_read_b128 v[32:35], v8 offset:0
    ds_read_b128 v[36:39], v8 offset:1024
    ds_read_b128 v[40:43], v8 offset:2048
    ds_read_b128 v[44:47], v8 offset:3072
    ds_read_b128 v[48:51], v8 offset:4096
    ds_read_b128 v[52:55], v8 offset:5120
    ds_read_b128 v[56:59], v8 offset:6144
    ds_read_b128 v[60:63], v8 offset:7168
    s_waitcnt lgkmcnt(7)
    v_pk_mul_f32 v[32:33], v[32:33], v[112:113] op_sel:[0,0] op_sel_hi:[1,0]
    v_pk_mul_f32 v[34:35], v[34:35], v[112:113] op_sel:[0,0] op_sel_hi:[1,0]
    s_waitcnt lgkmcnt(6)
    v_pk_fma_f32 v[32:33], v[36:37], v[112:113], v[32:33] op_sel:[0,1,0] op_sel_hi:[1,1,1]
    v_pk_fma_f32 v[34:35], v[38:39], v[112:113], v[34:35] op_sel:[0,1,0] op_sel_hi:[1,1,1]
    s_waitcnt lgkmcnt(5)
    v_pk_fma_f32 v[32:33], v[40:41], v[114:115], v[32:33] op_sel:[0,0,0] op_sel_hi:[1,0,1]
    v_pk_fma_f32 v[34:35], v[42:43], v[114:115], v[34:35] op_sel:[0,0,0] op_sel_hi:[1,0,1]
    s_waitcnt lgkmcnt(4)
    v_pk_fma_f32 v[32:33], v[44:45], v[114:115], v[32:33] op_sel:[0,1,0] op_sel_hi:[1,1,1]
    v_pk_fma_f32 v[34:35], v[46:47], v[114:115], v[34:35] op_sel:[0,1,0] op_sel_hi:[1,1,1]
    s_waitcnt lgkmcnt(3)
    v_pk_fma_f32 v[32:33], v[48:49], v[116:117], v[32:33] op_sel:[0,0,0] op_sel_hi:[1,0,1]
    v_pk_fma_f32 v[34:35], v[50:51], v[116:117], v[34:35] op_sel:[0,0,0] op_sel_hi:[1,0,1]
    s_waitcnt lgkmcnt(2)
    v_pk_fma_f32 v[32:33], v[52:53], v[116:117], v[32:33] op_sel:[0,1,0] op_sel_hi:[1,1,1]
    v_pk_fma_f32 v[34:35], v[54:55], v[116:117], v[34:35] op_sel:[0,1,0] op_sel_hi:[1,1,1]
    s_waitcnt lgkmcnt(1)
    v_pk_fma_f32 v[32:33], v[56:57], v[118:119], v[32:33] op_sel:[0,0,0] op_sel_hi:[1,0,1]
    v_pk_fma_f32 v[34:35], v[58:59], v[118:119], v[34:35] op_sel:[0,0,0] op_sel_hi:[1,0,1]
    s_waitcnt lgkmcnt(0)
    v_pk_fma_f32 v[32:33], v[60:61], v[118:119], v[32:33] op_sel:[0,1,0] op_sel_hi:[1,1,1]
    v_pk_fma_f32 v[34:35], v[62:63], v[118:119], v[34:35] op_sel:[0,1,0] op_sel_hi:[1,1,1]
    v_min_u32 v32, s56, v32
    v_min_u32 v33, s56, v33
    v_min_u32 v34, s56, v34
    v_min_u32 v35, s56, v35
    s_cmp_eq_u32 s50, 0
    s_cbranch_scc1 L_os
    global_store_dwordx4 v12, v[32:35], s[18:19]
    s_branch L_od
L_os:
    global_store_dwordx4 v13, v[32:35], s[18:19] sc1
    s_lshl_b32 s37, s52, 16
    v_mov_b32 v7, s37
    s_waitcnt vmcnt(0)
    s_mov_b64 exec, 1
    global_atomic_or v30, v7, s[16:17]
    s_mov_b64 exec, -1
L_od:
    s_cmp_eq_u32 s40, 0
    s_cbranch_scc1 L_exit
L_pb:
    s_cmp_eq_u32 s51, 0
    s_cbranch_scc1 L_pbs
    s_mov_b32 s41, 16
    global_load_dwordx4 v[64:67], v100, s[18:19] offset:-4096 nt
    global_load_dwordx4 v[68:71], v100, s[18:19] offset:0 nt
    global_load_dwordx4 v[72:75], v101, s[18:19] offset:-4096 nt
    global_load_dwordx4 v[76:79], v101, s[18:19] offset:0 nt
L_pf:
    global_load_dwordx4 v[80:83], v100, s[18:19] offset:-4096 nt
    global_load_dwordx4 v[84:87], v100, s[18:19] offset:0 nt
    global_load_dwordx4 v[88:91], v101, s[18:19] offset:-4096 nt
    global_load_dwordx4 v[92:95], v101, s[18:19] offset:0 nt
    s_waitcnt vmcnt(7)
    v_mul_f32 v24, v20, v64
    v_mul_f32 v25, v20, v65
    v_mul_f32 v26, v20, v66
    v_mul_f32 v27, v20, v67
    s_waitcnt vmcnt(6)
    v_fmac_f32 v24, v21, v68
    v_fmac_f32 v25, v21, v69
    v_fmac_f32 v26, v21, v70
    v_fmac_f32 v27, v21, v71
    s_waitcnt vmcnt(5)
    v_fmac_f32 v24, v22, v72
    v_fmac_f32 v25, v22, v73
    v_fmac_f32 v26, v22, v74
    v_fmac_f32 v27, v22, v75
    s_waitcnt vmcnt(4)
    v_fmac_f32 v24, v23, v76
    v_fmac_f32 v25, v23, v77
    v_fmac_f32 v26, v23, v78
    v_fmac_f32 v27, v23, v79
    s_nop 0
    v_permlane16_swap_b32 v24, v25
    v_permlane16_swap_b32 v26, v27
    s_nop 0
    v_add_f32 v24, v24, v25
    v_add_f32 v26, v26, v27
    s_nop 1
    v_permlane32_swap_b32 v24, v26
    s_nop 1
    v_add_f32 v24, v24, v26
    v_cmp_u_f32 vcc, v24, v24
    s_cbranch_vccz L_pdone
    v_max3_u32 v6, v64, v65, v66
    v_max3_u32 v7, v67, v68, v69
    v_max3_u32 v6, v6, v70, v71
    v_max3_u32 v7, v7, v72, v73
    v_max3_u32 v6, v6, v74, v75
    v_max3_u32 v7, v7, v76, v77
    v_max3_u32 v6, v6, v78, v79
    v_max_u32 v6, v6, v7
    v_cmp_eq_u32 vcc, -1, v6
    s_cbranch_vccz L_pdone
    global_load_dwordx4 v[64:67], v100, s[18:19] offset:-4096 nt
    global_load_dwordx4 v[68:71], v100, s[18:19] offset:0 nt
    global_load_dwordx4 v[72:75], v101, s[18:19] offset:-4096 nt
    global_load_dwordx4 v[76:79], v101, s[18:19] offset:0 nt
    s_waitcnt vmcnt(7)
    v_mul_f32 v24, v20, v80
    v_mul_f32 v25, v20, v81
    v_mul_f32 v26, v20, v82
    v_mul_f32 v27, v20, v83
    s_waitcnt vmcnt(6)
    v_fmac_f32 v24, v21, v84
    v_fmac_f32 v25, v21, v85
    v_fmac_f32 v26, v21, v86
    v_fmac_f32 v27, v21, v87
    s_waitcnt vmcnt(5)
    v_fmac_f32 v24, v22, v88
    v_fmac_f32 v25, v22, v89
    v_fmac_f32 v26, v22, v90
    v_fmac_f32 v27, v22, v91
    s_waitcnt vmcnt(4)
    v_fmac_f32 v24, v23, v92
    v_fmac_f32 v25, v23, v93
    v_fmac_f32 v26, v23, v94
    v_fmac_f32 v27, v23, v95
    s_nop 0
    v_permlane16_swap_b32 v24, v25
    v_permlane16_swap_b32 v26, v27
    s_nop 0
    v_add_f32 v24, v24, v25
    v_add_f32 v26, v26, v27
    s_nop 1
    v_permlane32_swap_b32 v24, v26
    s_nop 1
    v_add_f32 v24, v24, v26
    v_cmp_u_f32 vcc, v24, v24
    s_cbranch_vccz L_pdone
    v_max3_u32 v6, v80, v81, v82
    v_max3_u32 v7, v83, v84, v85
    v_max3_u32 v6, v6, v86, v87
    v_max3_u32 v7, v7, v88, v89
    v_max3_u32 v6, v6, v90, v91
    v_max3_u32 v7, v7, v92, v93
    v_max3_u32 v6, v6, v94, v95
    v_max_u32 v6, v6, v7
    v_cmp_eq_u32 vcc, -1, v6
    s_cbranch_vccz L_pdone
    s_sub_u32 s41, s41, 1
    s_cbranch_scc0 L_pf
L_pbs:
    s_sleep 4
    global_load_dwordx2 v[16:17], v1, s[16:17] offset:128 nt
    s_waitcnt vmcnt(0)
    v_readfirstlane_b32 s37, v16
    v_readfirstlane_b32 s43, v17
    s_nop 3
    s_and_b32 s37, s37, 0xff
    s_cmp_eq_u32 s37, s48
    s_cselect_b32 s51, 1, 0
    s_cmp_eq_u32 s43, s49
    s_cselect_b32 s50, s51, 0
    global_load_dword v31, v30, s[16:17] sc1
    s_sub_u32 s60, s60, 1
    s_cbranch_scc1 L_exit
    s_waitcnt vmcnt(0)
    v_bfe_u32 v31, v31, 16, 16
    s_nop 0
    v_readfirstlane_b32 s37, v31
    s_nop 3
    s_cmp_eq_u32 s37, 0xffff
    s_cselect_b32 s37, 1, s51
    s_cmp_eq_u32 s37, 0
    s_cbranch_scc1 L_pb
    v_lshrrev_b32 v31, v2, v31
    v_and_b32 v106, 1, v31
    v_cmp_ne_u32 vcc, 0, v106
    v_add_u32 v96, 0, v4
    v_add_u32 v106, 524288, v96
    v_cndmask_b32 v96, v106, v96, vcc
    v_and_b32 v106, 16, v31
    v_cmp_ne_u32 vcc, 0, v106
    v_add_u32 v97, 4096, v4
    v_add_u32 v106, 524288, v97
    v_cndmask_b32 v97, v106, v97, vcc
    v_and_b32 v106, 256, v31
    v_cmp_ne_u32 vcc, 0, v106
    v_add_u32 v98, 8192, v4
    v_add_u32 v106, 524288, v98
    v_cndmask_b32 v98, v106, v98, vcc
    v_and_b32 v106, 4096, v31
    v_cmp_ne_u32 vcc, 0, v106
    v_add_u32 v99, 12288, v4
    v_add_u32 v106, 524288, v99
    v_cndmask_b32 v99, v106, v99, vcc
    global_load_dwordx4 v[80:83], v96, s[18:19] sc1
    global_load_dwordx4 v[84:87], v97, s[18:19] sc1
    global_load_dwordx4 v[88:91], v98, s[18:19] sc1
    global_load_dwordx4 v[92:95], v99, s[18:19] sc1
    s_waitcnt vmcnt(3)
    v_mul_f32 v24, v20, v80
    v_mul_f32 v25, v20, v81
    v_mul_f32 v26, v20, v82
    v_mul_f32 v27, v20, v83
    s_waitcnt vmcnt(2)
    v_fmac_f32 v24, v21, v84
    v_fmac_f32 v25, v21, v85
    v_fmac_f32 v26, v21, v86
    v_fmac_f32 v27, v21, v87
    s_waitcnt vmcnt(1)
    v_fmac_f32 v24, v22, v88
    v_fmac_f32 v25, v22, v89
    v_fmac_f32 v26, v22, v90
    v_fmac_f32 v27, v22, v91
    s_waitcnt vmcnt(0)
    v_fmac_f32 v24, v23, v92
    v_fmac_f32 v25, v23, v93
    v_fmac_f32 v26, v23, v94
    v_fmac_f32 v27, v23, v95
    s_nop 0
    v_permlane16_swap_b32 v24, v25
    v_permlane16_swap_b32 v26, v27
    s_nop 0
    v_add_f32 v24, v24, v25
    v_add_f32 v26, v26, v27
    s_nop 1
    v_permlane32_swap_b32 v24, v26
    s_nop 1
    v_add_f32 v24, v24, v26
    v_cmp_u_f32 vcc, v24, v24
    s_cbranch_vccz L_pdone
    v_max3_u32 v6, v80, v81, v82
    v_max3_u32 v7, v83, v84, v85
    v_max3_u32 v6, v6, v86, v87
    v_max3_u32 v7, v7, v88, v89
    v_max3_u32 v6, v6, v90, v91
    v_max3_u32 v7, v7, v92, v93
    v_max3_u32 v6, v6, v94, v95
    v_max_u32 v6, v6, v7
    v_cmp_eq_u32 vcc, -1, v6
    s_cbranch_vccz L_pdone
    s_branch L_pb
L_pdone:
    v_cvt_pk_bf16_f32 v25, v24, v24
    global_store_short v9, v25, s[14:15]
L_exit:
L_end:
    s_endpgm
.section .rodata,"a"
.p2align 6
.amdhsa_kernel standalone__paged_block_table_kv_radixattention__decode_kernel
  .amdhsa_next_free_vgpr 160
  .amdhsa_next_free_sgpr 64
  .amdhsa_accum_offset 160
  .amdhsa_group_segment_fixed_size 0
  .amdhsa_kernarg_size 64
  .amdhsa_user_sgpr_count 2
  .amdhsa_user_sgpr_kernarg_segment_ptr 1
  .amdhsa_system_sgpr_workgroup_id_x 1
.end_amdhsa_kernel
```
